```python
import torch

def _softmax(x, axis=-1):
    return torch.softmax(x, dim=axis)
def _gelu(x):
    return torch.nn.functional.gelu(x, approximate="tanh")
def _silu(x):
    return torch.nn.functional.silu(x)
def _sigmoid(x):
    return torch.sigmoid(x)
def _layernorm(x, axis=-1, eps=1e-5):
    m = x.mean(dim=axis, keepdim=True)
    v = x.var(dim=axis, keepdim=True, unbiased=False)
    return (x - m) / torch.sqrt(v + eps)
def _scatter_add(tgt, idx, src, axis=0):
    return tgt.clone().index_add_(axis, idx, src)
def _segment_sum(src, seg, n):
    out = torch.zeros((n,) + src.shape[1:], dtype=src.dtype)
    return out.index_add_(0, seg, src)
def _pad(x, pw):
    flat = tuple(v for pair in reversed(pw) for v in pair)
    return torch.nn.functional.pad(x, flat)

kernel_name = 'standalone__grn__sampling'

def setup_inputs():

    _w = (lambda a: (lambda t: t.to(torch.bfloat16) if t.is_floating_point() else t)(torch.as_tensor(a)))
    B, S, D = 512, 32, 640
    return {
        "x": _w((lambda *s: torch.randn(*s, dtype=torch.bfloat16) * 0.05)(B, S, D)),
        "g": _w((lambda *s: torch.randn(*s, dtype=torch.bfloat16) * 0.8)(D) * 0.1),
        "b": _w((lambda *s: torch.randn(*s, dtype=torch.bfloat16) * 0.1)(D) * 0.1),
    }

def reference(x, g, b):
    gx = torch.sqrt((x * x).sum(axis=-2, keepdims=True))
    nx = gx / (gx.mean(axis=-1, keepdims=True) + 1e-6)
    return g * (x * nx) + b + x
```

```asm
; @launch grid=(512,1,1) block=(320,1,1) lds=1344
.amdgcn_target "amdgcn-amd-amdhsa--gfx950"
.text
.globl standalone__grn__sampling_kernel
.p2align 12
.p2align 8
.type standalone__grn__sampling_kernel,@function
standalone__grn__sampling_kernel:
    s_load_dwordx8 s[4:11], s[0:1], 0
    s_cmp_ge_u32 s2, 512
    s_cbranch_scc1 L_end
    s_mul_i32 s3, s2, 40960
    v_lshrrev_b32 v1, 6, v0
    v_and_b32 v2, 15, v0
    v_lshlrev_b32 v2, 4, v2
    s_lshr_b32 s13, s2, 3
    s_mul_i32 s14, s13, 205
    s_lshr_b32 s14, s14, 10
    s_mul_i32 s14, s14, 5
    s_sub_u32 s13, s13, s14
    v_add_u32 v4, s13, v1
    v_subrev_u32 v8, 5, v4
    v_min_u32 v4, v4, v8
    v_lshl_add_u32 v2, v4, 8, v2
    v_bfe_u32 v3, v0, 4, 2
    v_mul_u32_u24 v3, 1280, v3
    s_add_u32 s3, s3, 2560
    v_add3_u32 v16, v3, v2, s3
    v_add_u32 v17, 10240, v16
    v_add_u32 v18, 20480, v16
    v_add_u32 v19, 30720, v16
    v_and_b32 v8, 63, v0
    v_lshlrev_b32 v5, 2, v1
    v_lshl_add_u32 v9, v0, 2, 32
    v_cmp_eq_u32 vcc, 63, v8
    v_mov_b32 v6, 0
    v_mov_b32 v7, 0x358637bd
    s_mov_b32 s12, 0xffff0000
    v_cndmask_b32_e64 v5, v9, v5, vcc
    s_cmp_eq_u32 0, 0
    s_branch L_pad
L_back:
    s_cmp_eq_u32 0, 1
    s_waitcnt lgkmcnt(0)
.p2align 3
    global_load_dwordx4 v[96:99], v2, s[6:7]
    global_load_dwordx4 v[104:107], v2, s[8:9]
    global_load_dwordx4 v[24:27], v16, s[4:5] offset:-2560 nt
    global_load_dwordx4 v[32:35], v16, s[4:5] offset:2560 nt
    global_load_dwordx4 v[40:43], v17, s[4:5] offset:-2560 nt
    global_load_dwordx4 v[48:51], v17, s[4:5] offset:2560 nt
    global_load_dwordx4 v[56:59], v18, s[4:5] offset:-2560 nt
    global_load_dwordx4 v[64:67], v18, s[4:5] offset:2560 nt
    global_load_dwordx4 v[72:75], v19, s[4:5] offset:-2560 nt
    global_load_dwordx4 v[80:83], v19, s[4:5] offset:2560 nt
    s_waitcnt vmcnt(8)
    v_lshlrev_b32 v92, 16, v96
    v_and_b32 v93, 0xffff0000, v96
    v_lshlrev_b32 v94, 16, v97
    v_and_b32 v95, s12, v97
    v_lshlrev_b32 v96, 16, v98
    v_and_b32 v97, s12, v98
    v_lshlrev_b32 v98, 16, v99
    v_and_b32 v99, s12, v99
    v_lshlrev_b32 v100, 16, v104
    v_and_b32 v101, s12, v104
    v_lshlrev_b32 v102, 16, v105
    v_and_b32 v103, s12, v105
    v_lshlrev_b32 v104, 16, v106
    v_and_b32 v105, s12, v106
    v_lshlrev_b32 v106, 16, v107
    v_and_b32 v107, s12, v107
    s_waitcnt vmcnt(7)
    v_lshlrev_b32 v20, 16, v24
    v_and_b32 v21, 0xffff0000, v24
    v_lshlrev_b32 v22, 16, v25
    v_and_b32 v23, s12, v25
    v_lshlrev_b32 v24, 16, v26
    v_and_b32 v25, s12, v26
    v_lshlrev_b32 v26, 16, v27
    v_and_b32 v27, s12, v27
    v_pk_mul_f32 v[84:85], v[20:21], v[20:21]
    v_pk_mul_f32 v[86:87], v[22:23], v[22:23]
    v_pk_mul_f32 v[88:89], v[24:25], v[24:25]
    v_pk_mul_f32 v[90:91], v[26:27], v[26:27]
    s_waitcnt vmcnt(6)
    v_lshlrev_b32 v28, 16, v32
    v_and_b32 v29, 0xffff0000, v32
    v_lshlrev_b32 v30, 16, v33
    v_and_b32 v31, s12, v33
    v_lshlrev_b32 v32, 16, v34
    v_and_b32 v33, s12, v34
    v_lshlrev_b32 v34, 16, v35
    v_and_b32 v35, s12, v35
    v_pk_fma_f32 v[84:85], v[28:29], v[28:29], v[84:85]
    v_pk_fma_f32 v[86:87], v[30:31], v[30:31], v[86:87]
    v_pk_fma_f32 v[88:89], v[32:33], v[32:33], v[88:89]
    v_pk_fma_f32 v[90:91], v[34:35], v[34:35], v[90:91]
    s_waitcnt vmcnt(5)
    v_lshlrev_b32 v36, 16, v40
    v_and_b32 v37, 0xffff0000, v40
    v_lshlrev_b32 v38, 16, v41
    v_and_b32 v39, s12, v41
    v_lshlrev_b32 v40, 16, v42
    v_and_b32 v41, s12, v42
    v_lshlrev_b32 v42, 16, v43
    v_and_b32 v43, s12, v43
    v_pk_fma_f32 v[84:85], v[36:37], v[36:37], v[84:85]
    v_pk_fma_f32 v[86:87], v[38:39], v[38:39], v[86:87]
    v_pk_fma_f32 v[88:89], v[40:41], v[40:41], v[88:89]
    v_pk_fma_f32 v[90:91], v[42:43], v[42:43], v[90:91]
    s_waitcnt vmcnt(4)
    v_lshlrev_b32 v44, 16, v48
    v_and_b32 v45, 0xffff0000, v48
    v_lshlrev_b32 v46, 16, v49
    v_and_b32 v47, s12, v49
    v_lshlrev_b32 v48, 16, v50
    v_and_b32 v49, s12, v50
    v_lshlrev_b32 v50, 16, v51
    v_and_b32 v51, s12, v51
    v_pk_fma_f32 v[84:85], v[44:45], v[44:45], v[84:85]
    v_pk_fma_f32 v[86:87], v[46:47], v[46:47], v[86:87]
    v_pk_fma_f32 v[88:89], v[48:49], v[48:49], v[88:89]
    v_pk_fma_f32 v[90:91], v[50:51], v[50:51], v[90:91]
    s_waitcnt vmcnt(3)
    v_lshlrev_b32 v52, 16, v56
    v_and_b32 v53, 0xffff0000, v56
    v_lshlrev_b32 v54, 16, v57
    v_and_b32 v55, s12, v57
    v_lshlrev_b32 v56, 16, v58
    v_and_b32 v57, s12, v58
    v_lshlrev_b32 v58, 16, v59
    v_and_b32 v59, s12, v59
    v_pk_fma_f32 v[84:85], v[52:53], v[52:53], v[84:85]
    v_pk_fma_f32 v[86:87], v[54:55], v[54:55], v[86:87]
    v_pk_fma_f32 v[88:89], v[56:57], v[56:57], v[88:89]
    v_pk_fma_f32 v[90:91], v[58:59], v[58:59], v[90:91]
    s_waitcnt vmcnt(2)
    v_lshlrev_b32 v60, 16, v64
    v_and_b32 v61, 0xffff0000, v64
    v_lshlrev_b32 v62, 16, v65
    v_and_b32 v63, s12, v65
    v_lshlrev_b32 v64, 16, v66
    v_and_b32 v65, s12, v66
    v_lshlrev_b32 v66, 16, v67
    v_and_b32 v67, s12, v67
    v_pk_fma_f32 v[84:85], v[60:61], v[60:61], v[84:85]
    v_pk_fma_f32 v[86:87], v[62:63], v[62:63], v[86:87]
    v_pk_fma_f32 v[88:89], v[64:65], v[64:65], v[88:89]
    v_pk_fma_f32 v[90:91], v[66:67], v[66:67], v[90:91]
    s_waitcnt vmcnt(1)
    v_lshlrev_b32 v68, 16, v72
    v_and_b32 v69, 0xffff0000, v72
    v_lshlrev_b32 v70, 16, v73
    v_and_b32 v71, s12, v73
    v_lshlrev_b32 v72, 16, v74
    v_and_b32 v73, s12, v74
    v_lshlrev_b32 v74, 16, v75
    v_and_b32 v75, s12, v75
    v_pk_fma_f32 v[84:85], v[68:69], v[68:69], v[84:85]
    v_pk_fma_f32 v[86:87], v[70:71], v[70:71], v[86:87]
    v_pk_fma_f32 v[88:89], v[72:73], v[72:73], v[88:89]
    v_pk_fma_f32 v[90:91], v[74:75], v[74:75], v[90:91]
    s_waitcnt vmcnt(0)
    v_lshlrev_b32 v76, 16, v80
    v_and_b32 v77, 0xffff0000, v80
    v_lshlrev_b32 v78, 16, v81
    v_and_b32 v79, s12, v81
    v_lshlrev_b32 v80, 16, v82
    v_and_b32 v81, s12, v82
    v_lshlrev_b32 v82, 16, v83
    v_and_b32 v83, s12, v83
    v_pk_fma_f32 v[84:85], v[76:77], v[76:77], v[84:85]
    v_pk_fma_f32 v[86:87], v[78:79], v[78:79], v[86:87]
    v_pk_fma_f32 v[88:89], v[80:81], v[80:81], v[88:89]
    v_pk_fma_f32 v[90:91], v[82:83], v[82:83], v[90:91]
L_pad:
    s_cbranch_scc1 L_back
    v_permlane32_swap_b32 v84, v86
    v_permlane32_swap_b32 v85, v87
    v_permlane32_swap_b32 v88, v90
    v_permlane32_swap_b32_e64 v89, v91
    v_pk_add_f32 v[84:85], v[84:85], v[86:87]
    v_pk_add_f32 v[88:89], v[88:89], v[90:91]
    s_nop 1
    v_permlane16_swap_b32 v84, v88
    v_permlane16_swap_b32_e64 v85, v89
    v_pk_add_f32 v[84:85], v[84:85], v[88:89]
    v_sqrt_f32 v84, v84
    v_sqrt_f32 v85, v85
    s_nop 0
    v_add_f32 v8, v84, v85
    v_mov_b32 v88, v84
    v_mov_b32 v89, v85
    v_add_f32_dpp v8, v8, v8 row_ror:8 row_mask:0xf bank_mask:0xf
    v_permlane16_swap_b32 v84, v88
    v_permlane16_swap_b32 v85, v89
    v_add_f32_dpp v8, v8, v8 row_ror:4 row_mask:0xf bank_mask:0xf
    v_mov_b32 v86, v84
    v_mov_b32 v90, v88
    v_add_f32_dpp v8, v8, v8 row_ror:2 row_mask:0xf bank_mask:0xf
    v_mov_b32 v87, v85
    v_mov_b32 v91, v89
    v_add_f32_dpp v8, v8, v8 row_ror:1 row_mask:0xf bank_mask:0xf
    v_permlane32_swap_b32 v84, v86
    v_permlane32_swap_b32 v88, v90
    v_add_f32_dpp v8, v8, v8 row_bcast:15 row_mask:0xa bank_mask:0xf
    v_permlane32_swap_b32 v85, v87
    v_permlane32_swap_b32 v89, v91
    v_add_f32_dpp v8, v8, v8 row_bcast:31 row_mask:0xc bank_mask:0xf
    ds_write_b32 v5, v8
    s_waitcnt lgkmcnt(0)
    s_barrier
.p2align 3
    ds_read_b128 v[8:11], v6
    ds_read_b32 v12, v6 offset:16
    v_pk_mul_f32 v[92:93], v[92:93], v[84:85]
    v_pk_mul_f32 v[94:95], v[94:95], v[86:87]
    v_pk_mul_f32 v[96:97], v[96:97], v[88:89]
    v_pk_mul_f32 v[98:99], v[98:99], v[90:91]
    s_waitcnt lgkmcnt(0)
    v_add_f32 v8, v8, v12
    v_pk_add_f32 v[8:9], v[8:9], v[10:11]
    v_add_f32_e64 v8, v8, v9
    v_fmamk_f32 v8, v8, 0x3acccccd, v7
    v_rcp_f32 v8, v8
    s_nop 0
    v_pk_fma_f32 v[92:93], v[92:93], v[8:9], 1.0 op_sel_hi:[1,0,0]
    v_pk_fma_f32 v[94:95], v[94:95], v[8:9], 1.0 op_sel_hi:[1,0,0]
    v_pk_fma_f32 v[96:97], v[96:97], v[8:9], 1.0 op_sel_hi:[1,0,0]
    v_pk_fma_f32 v[98:99], v[98:99], v[8:9], 1.0 op_sel_hi:[1,0,0]
    v_pk_fma_f32 v[20:21], v[20:21], v[92:93], v[100:101]
    v_pk_fma_f32 v[22:23], v[22:23], v[94:95], v[102:103]
    v_pk_fma_f32 v[24:25], v[24:25], v[96:97], v[104:105]
    v_pk_fma_f32 v[26:27], v[26:27], v[98:99], v[106:107]
    v_cvt_pk_bf16_f32 v20, v20, v21
    v_cvt_pk_bf16_f32 v21, v22, v23
    v_cvt_pk_bf16_f32 v22, v24, v25
    v_cvt_pk_bf16_f32 v23, v26, v27
    global_store_dwordx4 v16, v[20:23], s[10:11] offset:-2560 nt
    v_pk_fma_f32 v[28:29], v[28:29], v[92:93], v[100:101]
    v_pk_fma_f32 v[30:31], v[30:31], v[94:95], v[102:103]
    v_pk_fma_f32 v[32:33], v[32:33], v[96:97], v[104:105]
    v_pk_fma_f32 v[34:35], v[34:35], v[98:99], v[106:107]
    v_cvt_pk_bf16_f32 v28, v28, v29
    v_cvt_pk_bf16_f32 v29, v30, v31
    v_cvt_pk_bf16_f32 v30, v32, v33
    v_cvt_pk_bf16_f32 v31, v34, v35
    global_store_dwordx4 v16, v[28:31], s[10:11] offset:2560 nt
    v_pk_fma_f32 v[36:37], v[36:37], v[92:93], v[100:101]
    v_pk_fma_f32 v[38:39], v[38:39], v[94:95], v[102:103]
    v_pk_fma_f32 v[40:41], v[40:41], v[96:97], v[104:105]
    v_pk_fma_f32 v[42:43], v[42:43], v[98:99], v[106:107]
    v_cvt_pk_bf16_f32 v36, v36, v37
    v_cvt_pk_bf16_f32 v37, v38, v39
    v_cvt_pk_bf16_f32 v38, v40, v41
    v_cvt_pk_bf16_f32 v39, v42, v43
    global_store_dwordx4 v17, v[36:39], s[10:11] offset:-2560 nt
    v_pk_fma_f32 v[44:45], v[44:45], v[92:93], v[100:101]
    v_pk_fma_f32 v[46:47], v[46:47], v[94:95], v[102:103]
    v_pk_fma_f32 v[48:49], v[48:49], v[96:97], v[104:105]
    v_pk_fma_f32 v[50:51], v[50:51], v[98:99], v[106:107]
    v_cvt_pk_bf16_f32 v44, v44, v45
    v_cvt_pk_bf16_f32 v45, v46, v47
    v_cvt_pk_bf16_f32 v46, v48, v49
    v_cvt_pk_bf16_f32 v47, v50, v51
    global_store_dwordx4 v17, v[44:47], s[10:11] offset:2560 nt
    v_pk_fma_f32 v[52:53], v[52:53], v[92:93], v[100:101]
    v_pk_fma_f32 v[54:55], v[54:55], v[94:95], v[102:103]
    v_pk_fma_f32 v[56:57], v[56:57], v[96:97], v[104:105]
    v_pk_fma_f32 v[58:59], v[58:59], v[98:99], v[106:107]
    v_cvt_pk_bf16_f32 v52, v52, v53
    v_cvt_pk_bf16_f32 v53, v54, v55
    v_cvt_pk_bf16_f32 v54, v56, v57
    v_cvt_pk_bf16_f32 v55, v58, v59
    global_store_dwordx4 v18, v[52:55], s[10:11] offset:-2560 nt
    v_pk_fma_f32 v[60:61], v[60:61], v[92:93], v[100:101]
    v_pk_fma_f32 v[62:63], v[62:63], v[94:95], v[102:103]
    v_pk_fma_f32 v[64:65], v[64:65], v[96:97], v[104:105]
    v_pk_fma_f32 v[66:67], v[66:67], v[98:99], v[106:107]
    v_cvt_pk_bf16_f32 v60, v60, v61
    v_cvt_pk_bf16_f32 v61, v62, v63
    v_cvt_pk_bf16_f32 v62, v64, v65
    v_cvt_pk_bf16_f32 v63, v66, v67
    global_store_dwordx4 v18, v[60:63], s[10:11] offset:2560 nt
    v_pk_fma_f32 v[68:69], v[68:69], v[92:93], v[100:101]
    v_pk_fma_f32 v[70:71], v[70:71], v[94:95], v[102:103]
    v_pk_fma_f32 v[72:73], v[72:73], v[96:97], v[104:105]
    v_pk_fma_f32 v[74:75], v[74:75], v[98:99], v[106:107]
    v_cvt_pk_bf16_f32 v68, v68, v69
    v_cvt_pk_bf16_f32 v69, v70, v71
    v_cvt_pk_bf16_f32 v70, v72, v73
    v_cvt_pk_bf16_f32 v71, v74, v75
    global_store_dwordx4 v19, v[68:71], s[10:11] offset:-2560 nt
    v_pk_fma_f32 v[76:77], v[76:77], v[92:93], v[100:101]
    v_pk_fma_f32 v[78:79], v[78:79], v[94:95], v[102:103]
    v_pk_fma_f32 v[80:81], v[80:81], v[96:97], v[104:105]
    v_pk_fma_f32 v[82:83], v[82:83], v[98:99], v[106:107]
    v_cvt_pk_bf16_f32 v76, v76, v77
    v_cvt_pk_bf16_f32 v77, v78, v79
    v_cvt_pk_bf16_f32 v78, v80, v81
    v_cvt_pk_bf16_f32 v79, v82, v83
    global_store_dwordx4 v19, v[76:79], s[10:11] offset:2560 nt
L_end:
    s_endpgm
.section .rodata,"a"
.p2align 6
.amdhsa_kernel standalone__grn__sampling_kernel
  .amdhsa_next_free_vgpr 108
  .amdhsa_next_free_sgpr 16
  .amdhsa_accum_offset 108
  .amdhsa_group_segment_fixed_size 0
  .amdhsa_kernarg_size 48
  .amdhsa_user_sgpr_count 2
  .amdhsa_user_sgpr_kernarg_segment_ptr 1
  .amdhsa_system_sgpr_workgroup_id_x 1
  .amdhsa_float_denorm_mode_32 3
.end_amdhsa_kernel
```
